```python
import torch

def _softmax(x, axis=-1):
    return torch.softmax(x, dim=axis)

def _gelu(x):
    return torch.nn.functional.gelu(x, approximate='tanh')

def _silu(x):
    return torch.nn.functional.silu(x)

def _sigmoid(x):
    return torch.sigmoid(x)

def _layernorm(x, axis=-1, eps=1e-05):
    m = x.mean(dim=axis, keepdim=True)
    v = x.var(dim=axis, keepdim=True, unbiased=False)
    return (x - m) / torch.sqrt(v + eps)

def _scatter_add(tgt, idx, src, axis=0):
    return tgt.clone().index_add_(axis, idx, src)

def _segment_sum(src, seg, n):
    out = torch.zeros((n,) + src.shape[1:], dtype=src.dtype)
    return out.index_add_(0, seg, src)

def _pad(x, pw):
    flat = tuple((v for pair in reversed(pw) for v in pair))
    return torch.nn.functional.pad(x, flat)
kernel_name = 'standalone__autoregressive_conv_wavenet__speech'

def setup_inputs():

    _w = lambda a: (lambda t: t.to(torch.bfloat16) if t.is_floating_point() else t)(torch.as_tensor(a))
    B, T, D, K = (2, 1000, 144, 31)
    return {'x': _w((lambda *s: torch.randn(*s, dtype=torch.bfloat16) * 0.1)(B, T, D)), 'w': _w((lambda *s: torch.randn(*s, dtype=torch.bfloat16) * 0.1)(K, D, 2 * D)), 'w_o': _w((lambda *s: torch.randn(*s, dtype=torch.bfloat16) * 0.05)(D, D))}

def reference(x, w, w_o):
    B, T, D = x.shape
    K = w.shape[0]
    dil = 2
    pad = (K - 1) * dil
    xp = _pad(x, ((0, 0), (pad, 0), (0, 0)))
    h = torch.einsum('btc,cd->btd', xp[:, pad:pad + T, :], w[0])
    for i in range(1, K):
        off = pad - i * dil
        h = h + torch.einsum('btc,cd->btd', xp[:, off:off + T, :], w[i])
    f = h[..., :D].clone()
    g = h[..., D:].clone()
    z = torch.tanh(f) * _sigmoid(g)
    return z @ w_o
```

```asm
; @launch grid=(252,1,1) block=(576,1,1) lds=160704
.amdgcn_target "amdgcn-amd-amdhsa--gfx950"
.text
.globl standalone__autoregressive_conv_wavenet__speech_kernel
.p2align 8
.type standalone__autoregressive_conv_wavenet__speech_kernel,@function
standalone__autoregressive_conv_wavenet__speech_kernel:
    s_cmp_ge_u32 s2, 252
    s_cbranch_scc1 L_done
    s_load_dwordx8 s[4:11], s[0:1], 0
    s_load_dwordx4 s[12:15], s[0:1], 32
    v_lshrrev_b32 v1, 6, v0
    v_and_b32 v0, 63, v0
    s_and_b32 s40, s2, 3
    v_readfirstlane_b32 s43, v1
    s_cmp_lg_u32 s43, 8
    s_cbranch_scc1 L_nopfc
    s_getpc_b64 s[56:57]
L_pc:
    s_lshr_b32 s60, s2, 3
    s_mul_i32 s60, s60, 384
    v_min_u32 v2, 5, v0
    v_lshlrev_b32 v2, 6, v2
    v_add_u32 v2, s60, v2
    v_min_u32 v2, L_end-L_pc-4, v2
    global_load_dword v47, v2, s[56:57]
L_nopfc:
    s_lshr_b32 s50, s2, 3
    s_and_b32 s51, s2, 4
    s_lshl_b32 s51, s51, 3
    s_add_u32 s50, s50, s51
    s_mul_i32 s42, s50, 57
    s_lshr_b32 s42, s42, 9
    s_mul_i32 s51, s42, 9
    s_sub_u32 s41, s50, s51
    s_lshl_b32 s48, s41, 2
    s_add_u32 s48, s48, s40
    s_lshr_b32 s50, s42, 1
    s_lshl_b32 s51, s42, 5
    s_mul_i32 s52, s50, 56
    s_sub_u32 s51, s51, s52
    s_sub_u32 s44, 56, s51
    s_min_u32 s44, s44, 32
    s_lshr_b32 s52, s40, 1
    s_mul_i32 s99, s52, 72
    s_and_b32 s100, s40, 1
    s_mul_i32 s98, s100, 40
    s_add_u32 s98, s98, s99
    s_add_u32 s99, s99, 32
    s_mov_b32 s63, 0x40000000
    s_mov_b32 s18, 0x8ca00
    s_mov_b32 s19, 0x20000
    s_mov_b32 s22, 0x273c00
    s_mov_b32 s23, 0x20000
    s_mov_b32 s26, 0xa200
    s_mov_b32 s27, 0x20000
    s_mov_b32 s30, 0x8ca00
    s_mov_b32 s31, 0x20000
    s_mov_b32 s34, 0x100
    s_mov_b32 s35, 0x20000
    s_mov_b32 s38, 0x589800
    s_mov_b32 s39, 0x20000
    s_cmp_eq_u32 s43, 8
    s_cbranch_scc1 L_control
    s_xor_b32 s43, s43, 4
    s_cmp_lt_u32 s43, 4
    s_cbranch_scc1 L_compute
L_dma:
    s_sub_u32 s49, s43, 4
    s_setprio 0
    v_mul_u32_u24 v8, 43, v0
    v_lshrrev_b32 v8, 8, v8
    v_mul_u32_u24 v7, 6, v8
    v_sub_u32 v7, v0, v7
    v_cmp_gt_u32 vcc, 4, v7
    s_lshl_b32 s52, s98, 1
    v_lshl_add_u32 v7, v7, 4, s52
    s_lshl_b32 s52, s99, 1
    v_mov_b32 v6, s52
    v_cndmask_b32 v7, v6, v7, vcc
    v_mul_u32_u24 v8, 576, v8
    v_add_u32 v20, v7, v8
    v_lshrrev_b32 v6, 2, v0
    v_mul_u32_u24 v6, 576, v6
    v_and_b32 v7, 3, v0
    v_lshrrev_b32 v8, 4, v0
    v_and_b32 v8, 2, v8
    v_xor_b32 v8, v8, v7
    v_lshl_add_u32 v31, v8, 4, v6
    s_lshl_b32 s52, s41, 6
    v_add_u32 v31, s52, v31
    s_mul_i32 s52, s98, 576
    v_add_u32 v30, s52, v31
    v_lshrrev_b32 v6, 5, v0
    v_mul_u32_u24 v6, 78336, v6
    v_add_u32 v31, v31, v6
    s_mul_i32 s45, s44, 9
    s_lshr_b32 s45, s45, 3
    s_add_u32 s45, s45, 4
    s_lshr_b32 s61, s49, 1
    s_mul_i32 s61, s61, 82944
    s_and_b32 s52, s49, 1
    s_mul_i32 s52, s52, 9216
    s_add_u32 s61, s61, s52
    s_lshl_b32 s60, s49, 10
    s_lshr_b32 s46, s50, 1
    s_mul_i32 s46, s46, 288000
    s_and_b32 s52, s50, 1
    s_mul_i32 s52, s52, 288
    s_add_u32 s46, s46, s52
    s_mul_i32 s51, s51, 5184
    s_add_u32 s46, s46, s51
    s_sub_u32 s46, s46, 18432
    s_add_u32 s50, s50, 1
    s_lshr_b32 s47, s50, 1
    s_mul_i32 s47, s47, 288000
    s_and_b32 s52, s50, 1
    s_mul_i32 s52, s52, 288
    s_add_u32 s47, s47, s52
    s_add_u32 s52, s45, 4
    s_mul_i32 s52, s52, 4608
    s_sub_u32 s47, s47, s52
    s_sub_u32 s47, s47, s46
    s_bitcmp1_b32 s42, 0
    s_cselect_b32 s47, s47, s63
    s_cselect_b32 s62, 44, 40
    s_cmp_eq_u32 s42, 0
    s_cselect_b32 s47, 0, s47
    s_cselect_b32 s45, 0, s45
    s_mul_i32 s53, s41, 9
    s_lshr_b32 s53, s53, 1
    s_add_u32 s53, s53, s49
    s_mul_i32 s89, s53, 768
    s_mul_i32 s88, s53, 4608
    s_add_u32 s88, s88, s46
    s_add_u32 s51, s88, s47
    s_cmp_lt_u32 s53, s45
    s_cselect_b32 s88, s88, s51
    s_sub_u32 s51, s53, s45
    s_cmp_lt_u32 s51, 4
    s_cselect_b32 s88, s63, s88
    s_cmp_lt_u32 s53, s62
    s_cselect_b32 s88, s88, s63
    s_lshl_b32 s51, s100, 3
    s_add_u32 s51, s51, s49
    s_mul_i32 s51, s51, 165888
    s_mul_i32 s52, s99, 576
    s_add_u32 s90, s51, s52
    s_and_b32 s94, s42, 1
    s_mul_i32 s94, s94, 580608
    s_sub_u32 s95, 0, s94
    s_waitcnt lgkmcnt(0)
    s_mov_b32 s16, s4
    s_and_b32 s17, s5, 0xffff
    s_mov_b32 s20, s6
    s_and_b32 s21, s7, 0xffff
    s_mov_b32 m0, s89
    s_mov_b32 exec_hi, 0xffff
    buffer_load_dwordx4 v20, s[16:19], s88 offen lds
    s_mov_b32 exec_hi, -1
    s_add_u32 m0, s60, 99328
    s_nop 0
    buffer_load_dwordx4 v31, s[20:23], s90 offen lds
    s_add_u32 m0, s60, 103424
    s_add_u32 s90, s90, 663552
    buffer_load_dwordx4 v31, s[20:23], s90 offen lds
    s_add_u32 m0, s60, 33792
    s_nop 0
    buffer_load_dwordx4 v30, s[20:23], s61 offen lds
    s_add_u32 s53, s53, 4
    s_sub_u32 s51, s53, 44
    s_cselect_b32 s53, s53, s51
    s_mul_i32 s89, s53, 768
    s_mul_i32 s88, s53, 4608
    s_add_u32 s88, s88, s46
    s_add_u32 s51, s88, s47
    s_cmp_lt_u32 s53, s45
    s_cselect_b32 s88, s88, s51
    s_sub_u32 s51, s53, s45
    s_cmp_lt_u32 s51, 4
    s_cselect_b32 s88, s63, s88
    s_cmp_lt_u32 s53, s62
    s_cselect_b32 s88, s88, s63
    s_mov_b32 m0, s89
    s_mov_b32 exec_hi, 0xffff
    buffer_load_dwordx4 v20, s[16:19], s88 offen lds
    s_mov_b32 exec_hi, -1
    s_add_u32 s53, s53, 4
    s_sub_u32 s51, s53, 44
    s_cselect_b32 s53, s53, s51
    s_mul_i32 s89, s53, 768
    s_mul_i32 s88, s53, 4608
    s_add_u32 s88, s88, s46
    s_add_u32 s51, s88, s47
    s_cmp_lt_u32 s53, s45
    s_cselect_b32 s88, s88, s51
    s_sub_u32 s51, s53, s45
    s_cmp_lt_u32 s51, 4
    s_cselect_b32 s88, s63, s88
    s_cmp_lt_u32 s53, s62
    s_cselect_b32 s88, s88, s63
    s_mov_b32 m0, s89
    s_mov_b32 exec_hi, 0xffff
    buffer_load_dwordx4 v20, s[16:19], s88 offen lds
    s_mov_b32 exec_hi, -1
    s_add_u32 s53, s53, 4
    s_sub_u32 s51, s53, 44
    s_cselect_b32 s53, s53, s51
    s_mul_i32 s89, s53, 768
    s_mul_i32 s88, s53, 4608
    s_add_u32 s88, s88, s46
    s_add_u32 s51, s88, s47
    s_cmp_lt_u32 s53, s45
    s_cselect_b32 s88, s88, s51
    s_sub_u32 s51, s53, s45
    s_cmp_lt_u32 s51, 4
    s_cselect_b32 s88, s63, s88
    s_cmp_lt_u32 s53, s62
    s_cselect_b32 s88, s88, s63
    s_mov_b32 m0, s89
    s_mov_b32 exec_hi, 0xffff
    buffer_load_dwordx4 v20, s[16:19], s88 offen lds
    s_mov_b32 exec_hi, -1
    s_add_u32 s53, s53, 4
    s_sub_u32 s51, s53, 44
    s_cselect_b32 s53, s53, s51
    s_mul_i32 s89, s53, 768
    s_mul_i32 s88, s53, 4608
    s_add_u32 s88, s88, s46
    s_add_u32 s51, s88, s47
    s_cmp_lt_u32 s53, s45
    s_cselect_b32 s88, s88, s51
    s_sub_u32 s51, s53, s45
    s_cmp_lt_u32 s51, 4
    s_cselect_b32 s88, s63, s88
    s_cmp_lt_u32 s53, s62
    s_cselect_b32 s88, s88, s63
    s_mov_b32 m0, s89
    s_mov_b32 exec_hi, 0xffff
    buffer_load_dwordx4 v20, s[16:19], s88 offen lds
    s_mov_b32 exec_hi, -1
    s_add_u32 s53, s53, 4
    s_sub_u32 s51, s53, 44
    s_cselect_b32 s53, s53, s51
    s_mul_i32 s89, s53, 768
    s_mul_i32 s88, s53, 4608
    s_add_u32 s88, s88, s46
    s_add_u32 s51, s88, s47
    s_cmp_lt_u32 s53, s45
    s_cselect_b32 s88, s88, s51
    s_sub_u32 s51, s53, s45
    s_cmp_lt_u32 s51, 4
    s_cselect_b32 s88, s63, s88
    s_cmp_lt_u32 s53, s62
    s_cselect_b32 s88, s88, s63
    s_mov_b32 m0, s89
    s_mov_b32 exec_hi, 0xffff
    buffer_load_dwordx4 v20, s[16:19], s88 offen lds
    s_mov_b32 exec_hi, -1
    s_add_u32 s53, s53, 4
    s_sub_u32 s51, s53, 44
    s_cselect_b32 s53, s53, s51
    s_mul_i32 s89, s53, 768
    s_mul_i32 s88, s53, 4608
    s_add_u32 s88, s88, s46
    s_add_u32 s51, s88, s47
    s_cmp_lt_u32 s53, s45
    s_cselect_b32 s88, s88, s51
    s_sub_u32 s51, s53, s45
    s_cmp_lt_u32 s51, 4
    s_cselect_b32 s88, s63, s88
    s_cmp_lt_u32 s53, s62
    s_cselect_b32 s88, s88, s63
    s_mov_b32 m0, s89
    s_mov_b32 exec_hi, 0xffff
    buffer_load_dwordx4 v20, s[16:19], s88 offen lds
    s_mov_b32 exec_hi, -1
    s_add_u32 s53, s53, 4
    s_sub_u32 s51, s53, 44
    s_cselect_b32 s53, s53, s51
    s_mul_i32 s89, s53, 768
    s_mul_i32 s88, s53, 4608
    s_add_u32 s88, s88, s46
    s_add_u32 s51, s88, s47
    s_cmp_lt_u32 s53, s45
    s_cselect_b32 s88, s88, s51
    s_sub_u32 s51, s53, s45
    s_cmp_lt_u32 s51, 4
    s_cselect_b32 s88, s63, s88
    s_cmp_lt_u32 s53, s62
    s_cselect_b32 s88, s88, s63
    s_mov_b32 m0, s89
    s_mov_b32 exec_hi, 0xffff
    buffer_load_dwordx4 v20, s[16:19], s88 offen lds
    s_mov_b32 exec_hi, -1
    s_add_u32 s53, s53, 4
    s_sub_u32 s51, s53, 44
    s_cselect_b32 s53, s53, s51
    s_mul_i32 s89, s53, 768
    s_mul_i32 s88, s53, 4608
    s_add_u32 s88, s88, s46
    s_add_u32 s51, s88, s47
    s_cmp_lt_u32 s53, s45
    s_cselect_b32 s88, s88, s51
    s_sub_u32 s51, s53, s45
    s_cmp_lt_u32 s51, 4
    s_cselect_b32 s88, s63, s88
    s_cmp_lt_u32 s53, s62
    s_cselect_b32 s88, s88, s63
    s_mov_b32 m0, s89
    s_mov_b32 exec_hi, 0xffff
    buffer_load_dwordx4 v20, s[16:19], s88 offen lds
    s_mov_b32 exec_hi, -1
    s_add_u32 s53, s53, 4
    s_sub_u32 s51, s53, 44
    s_cselect_b32 s53, s53, s51
    s_mul_i32 s89, s53, 768
    s_mul_i32 s88, s53, 4608
    s_add_u32 s88, s88, s46
    s_add_u32 s51, s88, s47
    s_cmp_lt_u32 s53, s45
    s_cselect_b32 s88, s88, s51
    s_sub_u32 s51, s53, s45
    s_cmp_lt_u32 s51, 4
    s_cselect_b32 s88, s63, s88
    s_cmp_lt_u32 s53, s62
    s_cselect_b32 s88, s88, s63
    s_mov_b32 m0, s89
    s_mov_b32 exec_hi, 0xffff
    buffer_load_dwordx4 v20, s[16:19], s88 offen lds
    s_mov_b32 exec_hi, -1
    s_add_u32 s53, s53, 4
    s_sub_u32 s51, s53, 44
    s_cselect_b32 s53, s53, s51
    s_mul_i32 s89, s53, 768
    s_mul_i32 s88, s53, 4608
    s_add_u32 s88, s88, s46
    s_add_u32 s51, s88, s47
    s_cmp_lt_u32 s53, s45
    s_cselect_b32 s88, s88, s51
    s_sub_u32 s51, s53, s45
    s_cmp_lt_u32 s51, 4
    s_cselect_b32 s88, s63, s88
    s_cmp_lt_u32 s53, s62
    s_cselect_b32 s88, s88, s63
    s_mov_b32 m0, s89
    s_mov_b32 exec_hi, 0xffff
    buffer_load_dwordx4 v20, s[16:19], s88 offen lds
    s_mov_b32 exec_hi, -1
    s_mov_b32 s36, s14
    s_and_b32 s37, s15, 0xffff
    s_mov_b32 s28, s10
    s_and_b32 s29, s11, 0xffff
    s_lshl_b32 s50, s49, 2
    s_add_u32 s50, s50, 155264
    v_mov_b32 v40, s50
    v_mov_b32 v41, 0
    ds_write_b32 v40, v41
    s_mov_b32 s24, s8
    s_and_b32 s25, s9, 0xffff
    s_mov_b32 s32, s12
    s_and_b32 s33, s13, 0xffff
    v_lshlrev_b32 v32, 4, v0
    v_add_u32 v32, s60, v32
    s_waitcnt vmcnt(4)
    s_add_u32 m0, s60, 37888
    s_add_u32 s61, s61, 165888
    buffer_load_dwordx4 v30, s[20:23], s61 offen lds
    s_waitcnt vmcnt(4)
    s_add_u32 m0, s60, 41984
    s_add_u32 s61, s61, 165888
    buffer_load_dwordx4 v30, s[20:23], s61 offen lds
    s_waitcnt vmcnt(4)
    s_add_u32 m0, s60, 46080
    s_add_u32 s61, s61, 165888
    buffer_load_dwordx4 v30, s[20:23], s61 offen lds
    s_waitcnt vmcnt(4)
    s_add_u32 m0, s60, 50176
    s_add_u32 s61, s61, 165888
    buffer_load_dwordx4 v30, s[20:23], s61 offen lds
    s_waitcnt vmcnt(4)
    s_waitcnt lgkmcnt(0)
    s_barrier
    s_add_u32 m0, s60, 54272
    s_add_u32 s61, s61, 165888
    buffer_load_dwordx4 v30, s[20:23], s61 offen lds
    s_waitcnt vmcnt(4)
    s_add_u32 m0, s60, 58368
    s_add_u32 s61, s61, 165888
    buffer_load_dwordx4 v30, s[20:23], s61 offen lds
    s_waitcnt vmcnt(4)
    v_mov_b32 v41, 1
    ds_write_b32 v40, v41
    s_add_u32 m0, s60, 62464
    s_add_u32 s61, s61, 165888
    buffer_load_dwordx4 v30, s[20:23], s61 offen lds
    s_waitcnt vmcnt(4)
    s_add_u32 m0, s60, 66560
    s_add_u32 s61, s61, 165888
    buffer_load_dwordx4 v30, s[20:23], s61 offen lds
    s_waitcnt vmcnt(4)
    v_mov_b32 v41, 2
    ds_write_b32 v40, v41
    s_add_u32 m0, s60, 70656
    s_add_u32 s61, s61, 165888
    buffer_load_dwordx4 v30, s[20:23], s61 offen lds
    s_waitcnt vmcnt(4)
    s_add_u32 m0, s60, 74752
    s_add_u32 s61, s61, 165888
    buffer_load_dwordx4 v30, s[20:23], s61 offen lds
    s_waitcnt vmcnt(4)
    s_add_u32 m0, s60, 78848
    s_add_u32 s61, s61, 165888
    buffer_load_dwordx4 v30, s[20:23], s61 offen lds
    s_waitcnt vmcnt(4)
    s_add_u32 m0, s60, 82944
    s_add_u32 s61, s61, 165888
    buffer_load_dwordx4 v30, s[20:23], s61 offen lds
    s_waitcnt vmcnt(4)
    v_mov_b32 v41, 3
    ds_write_b32 v40, v41
    s_add_u32 m0, s60, 87040
    s_add_u32 s61, s61, 165888
    buffer_load_dwordx4 v30, s[20:23], s61 offen lds
    s_waitcnt vmcnt(4)
    s_add_u32 m0, s60, 91136
    s_add_u32 s61, s61, 165888
    buffer_load_dwordx4 v30, s[20:23], s61 offen lds
    s_waitcnt vmcnt(4)
    s_add_u32 m0, s60, 95232
    s_add_u32 s61, s61, 165888
    buffer_load_dwordx4 v30, s[20:23], s61 offen lds
    s_waitcnt vmcnt(4)
    s_add_u32 m0, s60, 107520
    s_mov_b32 s51, 0
    buffer_load_dwordx4 v32, s[24:27], s51 offen lds
    s_waitcnt vmcnt(4)
    v_mov_b32 v41, 4
    ds_write_b32 v40, v41
    s_add_u32 m0, s60, 111616
    s_mov_b32 s51, 4096
    buffer_load_dwordx4 v32, s[24:27], s51 offen lds
    s_waitcnt vmcnt(4)
    s_add_u32 m0, s60, 115712
    s_mov_b32 s51, 8192
    buffer_load_dwordx4 v32, s[24:27], s51 offen lds
    s_waitcnt vmcnt(4)
    s_add_u32 m0, s60, 119808
    s_mov_b32 s51, 12288
    buffer_load_dwordx4 v32, s[24:27], s51 offen lds
    s_waitcnt vmcnt(4)
    v_mov_b32 v41, 5
    ds_write_b32 v40, v41
    s_add_u32 m0, s60, 123904
    s_mov_b32 s51, 16384
    buffer_load_dwordx4 v32, s[24:27], s51 offen lds
    s_add_u32 m0, s60, 128000
    s_mov_b32 s51, 20480
    buffer_load_dwordx4 v32, s[24:27], s51 offen lds
    s_add_u32 m0, s60, 132096
    s_mov_b32 s51, 24576
    buffer_load_dwordx4 v32, s[24:27], s51 offen lds
    s_add_u32 m0, s60, 136192
    s_mov_b32 s51, 28672
    buffer_load_dwordx4 v32, s[24:27], s51 offen lds
    s_add_u32 m0, s60, 140288
    s_mov_b32 s51, 32768
    buffer_load_dwordx4 v32, s[24:27], s51 offen lds
    s_add_u32 m0, s60, 144384
    s_mov_b32 s51, 36864
    buffer_load_dwordx4 v32, s[24:27], s51 offen lds
    s_waitcnt vmcnt(9)
    s_add_u32 m0, s60, 148480
    s_mov_b32 s51, 40960
    buffer_load_dwordx4 v32, s[24:27], s51 offen lds
    s_setprio 0
    v_lshlrev_b32 v164, 4, v0
    v_add_u32 v164, 155584, v164
    ds_read_b128 v[124:127], v164 offset:0
    ds_read_b128 v[128:131], v164 offset:1024
    ds_read_b128 v[132:135], v164 offset:2048
    ds_read_b128 v[136:139], v164 offset:3072
    ds_read_b64 v[140:141], v164 offset:4096
    s_waitcnt lgkmcnt(0)
    s_lshl_b32 s47, s43, 5
    v_add_u32 v138, s47, v138
    v_add_u32 v139, s47, v139
    s_sub_u32 s51, s47, 128
    v_add_u32 v134, s51, v134
    s_lshl_b32 s97, s51, 3
    s_add_u32 s96, s97, 1280
    s_cmp_lt_u32 s43, 8
    s_cselect_b32 s96, s96, s63
    s_cselect_b64 s[44:45], -1, 0
    s_or_b32 s57, s45, 0
    s_mov_b32 s56, -1
    v_mov_b32 v167, 0x40000000
    v_cndmask_b32 v133, v167, v133, s[56:57]
    s_lshl_b32 s51, s97, 2
    s_add_u32 s51, s51, 99328
    v_lshlrev_b32 v165, 4, v0
    v_add_u32 v165, s51, v165
    v_and_b32 v166, 48, v0
    v_lshlrev_b32 v166, 2, v166
    v_and_b32 v167, 3, v0
    v_lshl_add_u32 v166, v167, 4, v166
    v_and_b32 v167, 12, v0
    v_add3_u32 v166, v166, v167, s51
    s_waitcnt vmcnt(0)
    v_mov_b32 v41, 6
    ds_write_b32 v40, v41
    s_branch L_help
L_control:
    s_lshr_b32 s49, s2, 3
    v_mov_b32 v40, 155280
    v_mov_b32 v41, 0
    ds_write_b32 v40, v41
    ds_write_b32 v40, v41 offset:4
    v_min_u32 v22, 35, v0
    v_lshlrev_b32 v22, 7, v22
    v_lshlrev_b32 v32, 4, v0
    v_mov_b32 v42, 0
    v_mov_b32 v5, 0x40000000
    v_cmp_eq_u32 vcc, 0, v0
    s_memrealtime s[50:51]
    s_waitcnt lgkmcnt(0)
    v_cndmask_b32 v38, v5, v42, vcc
    s_mov_b32 s32, s12
    s_and_b32 s33, s13, 0xffff
    s_mov_b32 s20, s6
    s_and_b32 s21, s7, 0xffff
    s_mov_b32 s24, s8
    s_and_b32 s25, s9, 0xffff
    s_mov_b32 s36, s14
    s_and_b32 s37, s15, 0xffff
    s_mov_b32 s28, s10
    s_and_b32 s29, s11, 0xffff
    s_cmp_lg_u32 s2, 0
    s_cbranch_scc1 L_no_nonce
    s_or_b32 s50, s50, 1
    v_mov_b32 v1, s50
    buffer_store_dword v1, v38, s[32:35], 0 offen sc1
L_no_nonce:
    v_and_b32 v156, 15, v0
    v_lshrrev_b32 v157, 4, v0
    v_and_b32 v158, 1, v0
    v_lshlrev_b32 v158, 4, v158
    v_mov_b32 v159, 0x3f80
    v_lshlrev_b32 v159, v158, v159
    v_lshrrev_b32 v160, 1, v156
    v_cmp_eq_u32 s[56:57], 0, v160
    v_cmp_eq_u32 s[58:59], 1, v160
    s_nop 1
    v_cndmask_b32 v124, 0, v159, s[56:57]
    v_cndmask_b32 v128, 0, v159, s[58:59]
    v_cmp_eq_u32 s[56:57], 2, v160
    v_cmp_eq_u32 s[58:59], 3, v160
    s_nop 1
    v_cndmask_b32 v125, 0, v159, s[56:57]
    v_cndmask_b32 v129, 0, v159, s[58:59]
    v_cmp_eq_u32 s[56:57], 4, v160
    v_cmp_eq_u32 s[58:59], 5, v160
    s_nop 1
    v_cndmask_b32 v126, 0, v159, s[56:57]
    v_cndmask_b32 v130, 0, v159, s[58:59]
    v_cmp_eq_u32 s[56:57], 6, v160
    v_cmp_eq_u32 s[58:59], 7, v160
    s_nop 1
    v_cndmask_b32 v127, 0, v159, s[56:57]
    v_cndmask_b32 v131, 0, v159, s[58:59]
    s_mul_i32 s50, s42, 36
    s_add_u32 s50, s50, s48
    s_mul_i32 s50, s50, 23040
    v_mul_u32_u24 v132, 4608, v157
    v_lshl_add_u32 v132, v156, 4, v132
    v_add_u32 v132, s50, v132
    s_add_u32 s51, s50, 18432
    v_and_b32 v158, 1, v157
    v_mul_u32_u24 v133, 2304, v158
    v_lshrrev_b32 v158, 1, v157
    v_mul_u32_u24 v158, 1280, v158
    v_lshl_add_u32 v133, v156, 4, v133
    v_add3_u32 v133, v133, v158, s51
    v_and_b32 v158, 3, v156
    v_lshlrev_b32 v158, 1, v158
    v_lshrrev_b32 v159, 1, v157
    v_add_u32 v158, v158, v159
    v_mul_u32_u24 v134, 336, v158
    v_lshrrev_b32 v158, 2, v156
    v_lshl_add_u32 v134, v158, 3, v134
    v_and_b32 v158, 1, v157
    v_lshl_add_u32 v134, v158, 2, v134
    v_add_u32 v134, 152576, v134
    s_bfe_u32 s51, s48, 0x20002
    s_sub_u32 s51, 5, s51
    s_cmp_lt_u32 s48, 32
    s_cselect_b32 s51, s51, 1
    s_lshl_b32 s101, s51, 2
    v_min_u32 v158, 5, v0
    v_lshlrev_b32 v135, 2, v158
    v_add_u32 v135, 155264, v135
    v_mov_b32 v141, s101
    v_cmp_gt_u32 s[56:57], 4, v0
    v_cmp_eq_u32 s[58:59], 4, v0
    s_nop 1
    v_cndmask_b32 v141, v141, 0, s[56:57]
    v_cndmask_b32 v141, v141, 1, s[58:59]
    v_and_b32 v156, 15, v0
    v_lshrrev_b32 v157, 4, v0
    v_and_b32 v158, 7, v156
    v_mul_u32_u24 v158, 336, v158
    v_add_u32 v158, 152576, v158
    v_lshl_add_u32 v136, v157, 4, v158
    v_lshl_add_u32 v137, v157, 3, v158
    v_bfe_u32 v158, v0, 2, 2
    v_and_b32 v159, 3, v0
    v_lshlrev_b32 v159, 3, v159
    v_add_u32 v159, 107520, v159
    v_lshl_add_u32 v160, v157, 3, v158
    v_mul_u32_u24 v160, 288, v160
    v_add_u32 v138, v160, v159
    v_lshl_add_u32 v160, v157, 2, v158
    v_mul_u32_u24 v160, 288, v160
    v_add_u32 v139, v160, v159
    s_and_b32 s50, s48, 16
    s_and_b32 s51, s48, 3
    s_lshl_b32 s52, s51, 2
    s_add_u32 s50, s50, s52
    s_lshl_b32 s51, s51, 3
    s_lshr_b32 s52, s48, 1
    s_and_b32 s52, s52, 6
    s_cmp_lt_u32 s48, 32
    s_cselect_b64 s[56:57], -1, 0
    s_cselect_b32 s50, s50, s51
    s_cselect_b32 s51, s52, 8
    s_lshl_b32 s52, s42, 5
    s_add_u32 s50, s50, s52
    v_lshrrev_b32 v158, 1, v156
    v_cndmask_b32 v158, v156, v158, s[56:57]
    v_and_b32 v159, 1, v156
    v_cndmask_b32 v159, 0, v159, s[56:57]
    v_add_u32 v158, s50, v158
    v_add_u32 v159, s51, v159
    v_mul_u32_u24 v160, 1171, v158
    v_lshrrev_b32 v160, 16, v160
    v_mul_u32_u24 v161, 56, v160
    v_sub_u32 v158, v158, v161
    v_mul_u32_u24 v158, 9, v158
    v_add_u32 v158, v158, v159
    v_lshrrev_b32 v161, 1, v160
    v_mul_u32_u24 v161, 288000, v161
    v_and_b32 v160, 1, v160
    v_mul_u32_u24 v160, 288, v160
    v_mul_u32_u24 v159, 576, v158
    v_add3_u32 v159, v159, v160, v161
    v_lshl_add_u32 v159, v157, 3, v159
    v_mov_b32 v160, 500
    v_cmp_lt_u32 s[56:57], v158, v160
    v_cmp_gt_u32 s[58:59], 8, v156
    v_mov_b32 v160, 0x40000000
    s_and_b64 s[56:57], s[56:57], s[58:59]
    s_nop 1
    v_cndmask_b32 v140, v160, v159, s[56:57]
    v_lshlrev_b32 v164, 4, v0
    v_add_u32 v164, 155584, v164
    ds_write_b128 v164, v[124:127] offset:0
    ds_write_b128 v164, v[128:131] offset:1024
    ds_write_b128 v164, v[132:135] offset:2048
    ds_write_b128 v164, v[136:139] offset:3072
    ds_write_b64 v164, v[140:141] offset:4096
    s_lshl_b32 s47, s43, 5
    v_add_u32 v138, s47, v138
    v_add_u32 v139, s47, v139
    s_sub_u32 s51, s47, 128
    v_add_u32 v134, s51, v134
    s_lshl_b32 s97, s51, 3
    s_add_u32 s96, s97, 1280
    s_cmp_lt_u32 s43, 8
    s_cselect_b32 s96, s96, s63
    s_cselect_b64 s[44:45], -1, 0
    s_or_b32 s57, s45, 0
    s_mov_b32 s56, -1
    v_mov_b32 v167, 0x40000000
    v_cndmask_b32 v133, v167, v133, s[56:57]
    s_lshl_b32 s51, s97, 2
    s_add_u32 s51, s51, 99328
    v_lshlrev_b32 v165, 4, v0
    v_add_u32 v165, s51, v165
    v_and_b32 v166, 48, v0
    v_lshlrev_b32 v166, 2, v166
    v_and_b32 v167, 3, v0
    v_lshl_add_u32 v166, v167, 4, v166
    v_and_b32 v167, 12, v0
    v_add3_u32 v166, v166, v167, s51
    s_waitcnt lgkmcnt(0)
    s_barrier
    s_mov_b32 s55, 0
    s_mov_b64 exec, 0
    s_branch L_pad0
L_warm_done:
    s_mov_b64 exec, -1
    v_mov_b32 v42, 0
L_nonce:
    buffer_load_dword v43, v42, s[32:35], 0 offen sc1
    s_add_u32 s55, s55, 1
    s_cmp_lt_u32 s55, 262144
    s_cselect_b32 s51, 0, 1
    s_waitcnt vmcnt(0)
    v_or_b32 v43, s51, v43
    v_cmp_eq_u32 vcc, 0, v43
    s_cbranch_vccnz L_nonce
    ds_write_b32 v40, v43
    s_waitcnt lgkmcnt(0)
    s_branch L_help
L_compute:
    v_and_b32 v8, 15, v0
    v_lshrrev_b32 v9, 4, v0
    s_lshr_b32 s50, s43, 1
    s_and_b32 s51, s43, 1
    s_lshl_b32 s52, s50, 4
    v_add_u32 v10, s52, v8
    v_cmp_le_u32 vcc, s44, v10
    v_mul_u32_u24 v11, 9, v10
    v_add_u32 v11, 2, v11
    v_add_u32 v1, 32, v11
    v_cndmask_b32 v11, v11, v1, vcc
    v_mul_u32_u24 v1, 96, v11
    v_lshl_add_u32 v149, v9, 4, v1
    s_mul_i32 s52, s100, 1536
    s_sub_u32 s52, 1792, s52
    v_add_u32 v1, s52, v1
    v_mul_u32_u24 v10, 96, v9
    v_sub_u32 v1, v1, v10
    v_and_b32 v10, 1, v9
    v_lshl_add_u32 v3, v10, 4, v1
    v_and_b32 v10, 1, v9
    v_lshlrev_b32 v1, 1, v10
    v_bfe_u32 v10, v0, 2, 2
    v_lshl_add_u32 v10, v9, 3, v10
    v_lshlrev_b32 v4, 6, v10
    v_bfe_u32 v10, v0, 1, 1
    s_lshl_b32 s52, s51, 1
    v_add_u32 v10, s52, v10
    v_xor_b32 v10, v10, v1
    v_lshl_add_u32 v4, v10, 4, v4
    v_and_b32 v10, 1, v0
    v_lshl_add_u32 v4, v10, 3, v4
    v_add_u32 v4, 33792, v4
    v_add_u32 v5, 65536, v4
    v_and_b32 v10, 3, v0
    v_lshlrev_b32 v10, 2, v10
    v_add_u32 v2, 155264, v10
    s_mul_i32 s52, s40, 4608
    s_lshl_b32 s53, s41, 9
    s_add_u32 s52, s52, s53
    s_lshl_b32 s53, s51, 8
    s_add_u32 s52, s52, s53
    s_mul_i32 s53, s42, 829440
    s_add_u32 s52, s52, s53
    v_lshlrev_b32 v10, 6, v9
    v_add_u32 v10, s52, v10
    s_mul_i32 s53, s50, 368640
    v_lshrrev_b32 v1, 2, v8
    v_mul_u32_u24 v1, 23040, v1
    v_add3_u32 v6, v10, v1, s53
    v_and_b32 v1, 3, v8
    v_lshl_add_u32 v6, v1, 4, v6
    s_mul_i32 s53, s50, 46080
    s_add_u32 s53, s53, 737280
    v_lshrrev_b32 v1, 3, v8
    v_mul_u32_u24 v1, 23040, v1
    v_add3_u32 v7, v10, v1, s53
    v_and_b32 v1, 7, v8
    v_lshl_add_u32 v7, v1, 3, v7
    s_lshl_b32 s52, s40, 6
    s_lshl_b32 s53, s41, 9
    s_add_u32 s52, s52, s53
    s_lshl_b32 s53, s51, 8
    s_add_u32 s52, s52, s53
    s_mul_i32 s53, s42, 829440
    s_add_u32 s52, s52, s53
    s_add_u32 s52, s52, 18432
    s_mul_i32 s53, s50, 368640
    s_add_u32 s53, s53, s52
    v_lshrrev_b32 v1, 2, v8
    v_mul_u32_u24 v1, 23040, v1
    v_and_b32 v10, 3, v8
    v_lshl_add_u32 v1, v10, 4, v1
    v_add_u32 v151, s53, v1
    s_mul_i32 s53, s50, 46080
    s_add_u32 s53, s53, 737280
    s_add_u32 s53, s53, s52
    v_lshrrev_b32 v1, 3, v8
    v_mul_u32_u24 v1, 23040, v1
    v_bfe_u32 v10, v8, 1, 2
    v_lshl_add_u32 v1, v10, 4, v1
    v_add_u32 v152, s53, v1
    v_cmp_gt_u32 vcc, 16, v0
    v_and_b32 v10, 0x31, v0
    v_cmp_eq_u32 s[56:57], 0, v10
    v_mov_b32 v1, 0x40000000
    v_cndmask_b32 v151, v1, v151, vcc
    v_cndmask_b32 v152, v1, v152, s[56:57]
    v_cmp_eq_u32 vcc, 0, v0
    v_lshlrev_b32 v155, 2, v0
    v_add_u32 v155, 155284, v155
    v_mov_b32 v150, 155280
    v_cndmask_b32 v154, 0, 1, vcc
    s_mov_b32 s60, 92160
    s_mov_b32 s61, 184320
    s_mov_b32 s62, 276480
    v_lshlrev_b32 v164, 4, v0
    v_add_u32 v164, 155584, v164
    s_waitcnt lgkmcnt(0)
    s_mov_b32 s36, s14
    s_and_b32 s37, s15, 0xffff
    s_mov_b32 s28, s10
    s_and_b32 s29, s11, 0xffff
    s_mov_b32 s24, s8
    s_and_b32 s25, s9, 0xffff
    s_mov_b32 s32, s12
    s_and_b32 s33, s13, 0xffff
    s_waitcnt lgkmcnt(0)
    s_and_b32 s50, s42, 1
    s_mul_i32 s50, s50, 672
    v_subrev_u32 v9, s50, v149
    v_add_u32 v10, s50, v149
    s_setprio 2
    s_barrier
    ds_read_b64_tr_b16 v[48:49], v5 offset:0
    ds_read_b64_tr_b16 v[50:51], v5 offset:256
    ds_read_b128 v[52:55], v3 offset:1920
    ds_read_b128 v[56:59], v3 offset:1824
    ds_read_b128 v[60:63], v3 offset:1728
    ds_read_b128 v[64:67], v3 offset:1632
    ds_read_b128 v[68:71], v3 offset:1536
    ds_read_b128 v[72:75], v3 offset:1440
    ds_read_b128 v[76:79], v3 offset:1344
    ds_read_b128 v[80:83], v3 offset:1248
    ds_read_b128 v[84:87], v3 offset:1152
    ds_read_b64_tr_b16 v[88:89], v5 offset:2048
    ds_read_b64_tr_b16 v[90:91], v5 offset:2304
    s_waitcnt lgkmcnt(10)
    v_mfma_f32_16x16x32_bf16 v[44:47], v[48:51], v[52:55], 0
    ds_read_b128 v[92:95], v3 offset:1056
    ds_read_b128 v[96:99], v3 offset:960
    s_waitcnt lgkmcnt(11)
    v_mfma_f32_16x16x32_bf16 v[40:43], v[48:51], v[56:59], 0
    ds_read_b128 v[100:103], v3 offset:864
    s_waitcnt lgkmcnt(11)
    v_mfma_f32_16x16x32_bf16 v[36:39], v[48:51], v[60:63], 0
    ds_read_b128 v[104:107], v3 offset:768
    s_waitcnt lgkmcnt(11)
    v_mfma_f32_16x16x32_bf16 v[32:35], v[48:51], v[64:67], 0
    ds_read_b64_tr_b16 v[108:109], v5 offset:4096
    ds_read_b64_tr_b16 v[110:111], v5 offset:4352
    s_waitcnt lgkmcnt(12)
    v_mfma_f32_16x16x32_bf16 v[28:31], v[48:51], v[68:71], 0
    s_waitcnt lgkmcnt(11)
    v_mfma_f32_16x16x32_bf16 v[24:27], v[48:51], v[72:75], 0
    s_waitcnt lgkmcnt(10)
    v_mfma_f32_16x16x32_bf16 v[20:23], v[48:51], v[76:79], 0
    s_waitcnt lgkmcnt(9)
    v_mfma_f32_16x16x32_bf16 v[16:19], v[48:51], v[80:83], 0
    s_waitcnt lgkmcnt(8)
    v_mfma_f32_16x16x32_bf16 v[12:15], v[48:51], v[84:87], 0
    ds_read_b128 v[112:115], v3 offset:672
    s_waitcnt lgkmcnt(7)
    v_mfma_f32_16x16x32_bf16 v[44:47], v[88:91], v[68:71], v[44:47]
    ds_read_b128 v[116:119], v3 offset:576
    v_mfma_f32_16x16x32_bf16 v[40:43], v[88:91], v[72:75], v[40:43]
    ds_read_b128 v[120:123], v3 offset:480
    v_mfma_f32_16x16x32_bf16 v[36:39], v[88:91], v[76:79], v[36:39]
    ds_read_b128 v[124:127], v3 offset:384
    v_mfma_f32_16x16x32_bf16 v[32:35], v[88:91], v[80:83], v[32:35]
    ds_read_b64_tr_b16 v[128:129], v5 offset:6144
    ds_read_b64_tr_b16 v[130:131], v5 offset:6400
    v_mfma_f32_16x16x32_bf16 v[28:31], v[88:91], v[84:87], v[28:31]
    s_waitcnt lgkmcnt(6)
    v_mfma_f32_16x16x32_bf16 v[24:27], v[88:91], v[92:95], v[24:27]
    v_mfma_f32_16x16x32_bf16 v[20:23], v[88:91], v[96:99], v[20:23]
    v_mfma_f32_16x16x32_bf16 v[16:19], v[88:91], v[100:103], v[16:19]
    v_mfma_f32_16x16x32_bf16 v[12:15], v[88:91], v[104:107], v[12:15]
    ds_read_b128 v[132:135], v3 offset:288
    v_mfma_f32_16x16x32_bf16 v[44:47], v[108:111], v[84:87], v[44:47]
    ds_read_b128 v[136:139], v3 offset:192
    v_mfma_f32_16x16x32_bf16 v[40:43], v[108:111], v[92:95], v[40:43]
    ds_read_b128 v[52:55], v3 offset:96
    v_mfma_f32_16x16x32_bf16 v[36:39], v[108:111], v[96:99], v[36:39]
    ds_read_b128 v[56:59], v3 offset:0
    v_mfma_f32_16x16x32_bf16 v[32:35], v[108:111], v[100:103], v[32:35]
    ds_read_b64_tr_b16 v[60:61], v4 offset:0
    ds_read_b64_tr_b16 v[62:63], v4 offset:256
    v_mfma_f32_16x16x32_bf16 v[28:31], v[108:111], v[104:107], v[28:31]
    s_waitcnt lgkmcnt(6)
    ds_read_b128 v[64:67], v149 offset:3648
    v_mfma_f32_16x16x32_bf16 v[24:27], v[108:111], v[112:115], v[24:27]
    ds_read_b128 v[48:51], v149 offset:3552
    v_mfma_f32_16x16x32_bf16 v[20:23], v[108:111], v[116:119], v[20:23]
    ds_read_b128 v[68:71], v149 offset:3456
    v_mfma_f32_16x16x32_bf16 v[16:19], v[108:111], v[120:123], v[16:19]
    ds_read_b128 v[72:75], v149 offset:3360
    v_mfma_f32_16x16x32_bf16 v[12:15], v[108:111], v[124:127], v[12:15]
    ds_read_b128 v[76:79], v149 offset:3264
    v_mfma_f32_16x16x32_bf16 v[44:47], v[128:131], v[104:107], v[44:47]
    s_waitcnt lgkmcnt(8)
    ds_read_b128 v[80:83], v149 offset:3168
    v_mfma_f32_16x16x32_bf16 v[40:43], v[128:131], v[112:115], v[40:43]
    ds_read_b128 v[88:91], v149 offset:3072
    v_mfma_f32_16x16x32_bf16 v[36:39], v[128:131], v[116:119], v[36:39]
L_pad0:
    s_cbranch_execz L_pad1
    ds_read_b128 v[84:87], v149 offset:2976
    v_mfma_f32_16x16x32_bf16 v[32:35], v[128:131], v[120:123], v[32:35]
    s_waitcnt lgkmcnt(7)
    ds_read_b128 v[92:95], v149 offset:2880
    v_mfma_f32_16x16x32_bf16 v[28:31], v[128:131], v[124:127], v[28:31]
    ds_read_b64_tr_b16 v[96:97], v4 offset:2048
    ds_read_b64_tr_b16 v[98:99], v4 offset:2304
    v_mfma_f32_16x16x32_bf16 v[24:27], v[128:131], v[132:135], v[24:27]
    v_mfma_f32_16x16x32_bf16 v[20:23], v[128:131], v[136:139], v[20:23]
    v_mfma_f32_16x16x32_bf16 v[16:19], v[128:131], v[52:55], v[16:19]
    v_mfma_f32_16x16x32_bf16 v[12:15], v[128:131], v[56:59], v[12:15]
    v_mfma_f32_16x16x32_bf16 v[44:47], v[60:63], v[64:67], v[44:47]
    s_waitcnt lgkmcnt(9)
    v_mfma_f32_16x16x32_bf16 v[40:43], v[60:63], v[48:51], v[40:43]
    s_waitcnt lgkmcnt(8)
    v_mfma_f32_16x16x32_bf16 v[36:39], v[60:63], v[68:71], v[36:39]
    ds_read_b128 v[100:103], v149 offset:2784
    s_waitcnt lgkmcnt(8)
    v_mfma_f32_16x16x32_bf16 v[32:35], v[60:63], v[72:75], v[32:35]
    ds_read_b32 v148, v2
    s_waitcnt lgkmcnt(8)
    v_mfma_f32_16x16x32_bf16 v[28:31], v[60:63], v[76:79], v[28:31]
    s_waitcnt lgkmcnt(7)
    v_mfma_f32_16x16x32_bf16 v[24:27], v[60:63], v[80:83], v[24:27]
    s_waitcnt lgkmcnt(6)
    v_mfma_f32_16x16x32_bf16 v[20:23], v[60:63], v[88:91], v[20:23]
    s_waitcnt lgkmcnt(5)
    v_mfma_f32_16x16x32_bf16 v[16:19], v[60:63], v[84:87], v[16:19]
    s_waitcnt lgkmcnt(4)
    v_mfma_f32_16x16x32_bf16 v[12:15], v[60:63], v[92:95], v[12:15]
    s_waitcnt lgkmcnt(2)
    v_mfma_f32_16x16x32_bf16 v[44:47], v[96:99], v[48:51], v[44:47]
    v_mfma_f32_16x16x32_bf16 v[40:43], v[96:99], v[68:71], v[40:43]
L_chk1:
    s_waitcnt lgkmcnt(0)
    v_cmp_gt_u32 vcc, 1, v148
    ds_read_b32 v148, v2
    s_cbranch_vccnz L_chk1
    ds_read_b64_tr_b16 v[108:109], v4 offset:4096
    ds_read_b64_tr_b16 v[110:111], v4 offset:4352
    v_mfma_f32_16x16x32_bf16 v[36:39], v[96:99], v[72:75], v[36:39]
    ds_read_b128 v[104:107], v149 offset:2688
    v_mfma_f32_16x16x32_bf16 v[32:35], v[96:99], v[76:79], v[32:35]
    ds_read_b64_tr_b16 v[112:113], v4 offset:6144
    ds_read_b64_tr_b16 v[114:115], v4 offset:6400
    v_mfma_f32_16x16x32_bf16 v[28:31], v[96:99], v[80:83], v[28:31]
    v_mfma_f32_16x16x32_bf16 v[24:27], v[96:99], v[88:91], v[24:27]
    v_mfma_f32_16x16x32_bf16 v[20:23], v[96:99], v[84:87], v[20:23]
    v_mfma_f32_16x16x32_bf16 v[16:19], v[96:99], v[92:95], v[16:19]
    v_mfma_f32_16x16x32_bf16 v[12:15], v[96:99], v[100:103], v[12:15]
    s_waitcnt lgkmcnt(3)
    v_mfma_f32_16x16x32_bf16 v[44:47], v[108:111], v[68:71], v[44:47]
    v_mfma_f32_16x16x32_bf16 v[40:43], v[108:111], v[72:75], v[40:43]
    v_mfma_f32_16x16x32_bf16 v[36:39], v[108:111], v[76:79], v[36:39]
    ds_read_b128 v[116:119], v149 offset:2592
    v_mfma_f32_16x16x32_bf16 v[32:35], v[108:111], v[80:83], v[32:35]
    ds_read_b64_tr_b16 v[120:121], v4 offset:8192
    ds_read_b64_tr_b16 v[122:123], v4 offset:8448
    v_mfma_f32_16x16x32_bf16 v[28:31], v[108:111], v[88:91], v[28:31]
    v_mfma_f32_16x16x32_bf16 v[24:27], v[108:111], v[84:87], v[24:27]
    v_mfma_f32_16x16x32_bf16 v[20:23], v[108:111], v[92:95], v[20:23]
    v_mfma_f32_16x16x32_bf16 v[16:19], v[108:111], v[100:103], v[16:19]
    s_waitcnt lgkmcnt(5)
    v_mfma_f32_16x16x32_bf16 v[12:15], v[108:111], v[104:107], v[12:15]
    s_waitcnt lgkmcnt(3)
    v_mfma_f32_16x16x32_bf16 v[44:47], v[112:115], v[72:75], v[44:47]
    v_mfma_f32_16x16x32_bf16 v[40:43], v[112:115], v[76:79], v[40:43]
    v_mfma_f32_16x16x32_bf16 v[36:39], v[112:115], v[80:83], v[36:39]
    ds_read_b128 v[124:127], v149 offset:2496
    v_mfma_f32_16x16x32_bf16 v[32:35], v[112:115], v[88:91], v[32:35]
    ds_read_b64_tr_b16 v[132:133], v4 offset:10240
    ds_read_b64_tr_b16 v[134:135], v4 offset:10496
    v_mfma_f32_16x16x32_bf16 v[28:31], v[112:115], v[84:87], v[28:31]
    v_mfma_f32_16x16x32_bf16 v[24:27], v[112:115], v[92:95], v[24:27]
    v_mfma_f32_16x16x32_bf16 v[20:23], v[112:115], v[100:103], v[20:23]
    v_mfma_f32_16x16x32_bf16 v[16:19], v[112:115], v[104:107], v[16:19]
    s_waitcnt lgkmcnt(5)
    v_mfma_f32_16x16x32_bf16 v[12:15], v[112:115], v[116:119], v[12:15]
    s_waitcnt lgkmcnt(3)
    v_mfma_f32_16x16x32_bf16 v[44:47], v[120:123], v[76:79], v[44:47]
    v_mfma_f32_16x16x32_bf16 v[40:43], v[120:123], v[80:83], v[40:43]
    v_mfma_f32_16x16x32_bf16 v[36:39], v[120:123], v[88:91], v[36:39]
    ds_read_b128 v[136:139], v149 offset:2400
    v_mfma_f32_16x16x32_bf16 v[32:35], v[120:123], v[84:87], v[32:35]
    ds_read_b32 v148, v2
    v_mfma_f32_16x16x32_bf16 v[28:31], v[120:123], v[92:95], v[28:31]
    v_mfma_f32_16x16x32_bf16 v[24:27], v[120:123], v[100:103], v[24:27]
    v_mfma_f32_16x16x32_bf16 v[20:23], v[120:123], v[104:107], v[20:23]
    v_mfma_f32_16x16x32_bf16 v[16:19], v[120:123], v[116:119], v[16:19]
    s_waitcnt lgkmcnt(4)
    v_mfma_f32_16x16x32_bf16 v[12:15], v[120:123], v[124:127], v[12:15]
    s_waitcnt lgkmcnt(2)
    v_mfma_f32_16x16x32_bf16 v[44:47], v[132:135], v[80:83], v[44:47]
    v_mfma_f32_16x16x32_bf16 v[40:43], v[132:135], v[88:91], v[40:43]
L_chk2:
    s_waitcnt lgkmcnt(0)
    v_cmp_gt_u32 vcc, 2, v148
    ds_read_b32 v148, v2
    s_cbranch_vccnz L_chk2
    ds_read_b64_tr_b16 v[52:53], v4 offset:12288
    ds_read_b64_tr_b16 v[54:55], v4 offset:12544
    v_mfma_f32_16x16x32_bf16 v[36:39], v[132:135], v[84:87], v[36:39]
    ds_read_b128 v[128:131], v149 offset:2304
    v_mfma_f32_16x16x32_bf16 v[32:35], v[132:135], v[92:95], v[32:35]
    ds_read_b64_tr_b16 v[56:57], v4 offset:14336
    ds_read_b64_tr_b16 v[58:59], v4 offset:14592
    v_mfma_f32_16x16x32_bf16 v[28:31], v[132:135], v[100:103], v[28:31]
    v_mfma_f32_16x16x32_bf16 v[24:27], v[132:135], v[104:107], v[24:27]
    v_mfma_f32_16x16x32_bf16 v[20:23], v[132:135], v[116:119], v[20:23]
    v_mfma_f32_16x16x32_bf16 v[16:19], v[132:135], v[124:127], v[16:19]
    v_mfma_f32_16x16x32_bf16 v[12:15], v[132:135], v[136:139], v[12:15]
    s_waitcnt lgkmcnt(3)
    v_mfma_f32_16x16x32_bf16 v[44:47], v[52:55], v[88:91], v[44:47]
    v_mfma_f32_16x16x32_bf16 v[40:43], v[52:55], v[84:87], v[40:43]
    v_mfma_f32_16x16x32_bf16 v[36:39], v[52:55], v[92:95], v[36:39]
    ds_read_b128 v[64:67], v149 offset:2208
    v_mfma_f32_16x16x32_bf16 v[32:35], v[52:55], v[100:103], v[32:35]
    ds_read_b64_tr_b16 v[60:61], v4 offset:16384
    ds_read_b64_tr_b16 v[62:63], v4 offset:16640
    v_mfma_f32_16x16x32_bf16 v[28:31], v[52:55], v[104:107], v[28:31]
    v_mfma_f32_16x16x32_bf16 v[24:27], v[52:55], v[116:119], v[24:27]
    v_mfma_f32_16x16x32_bf16 v[20:23], v[52:55], v[124:127], v[20:23]
L_pad1:
    s_cbranch_execz L_pad2
    v_mfma_f32_16x16x32_bf16 v[16:19], v[52:55], v[136:139], v[16:19]
    s_waitcnt lgkmcnt(5)
    v_mfma_f32_16x16x32_bf16 v[12:15], v[52:55], v[128:131], v[12:15]
    s_waitcnt lgkmcnt(3)
    v_mfma_f32_16x16x32_bf16 v[44:47], v[56:59], v[84:87], v[44:47]
    v_mfma_f32_16x16x32_bf16 v[40:43], v[56:59], v[92:95], v[40:43]
    v_mfma_f32_16x16x32_bf16 v[36:39], v[56:59], v[100:103], v[36:39]
    ds_read_b128 v[48:51], v149 offset:2112
    v_mfma_f32_16x16x32_bf16 v[32:35], v[56:59], v[104:107], v[32:35]
    ds_read_b64_tr_b16 v[96:97], v4 offset:18432
    ds_read_b64_tr_b16 v[98:99], v4 offset:18688
    v_mfma_f32_16x16x32_bf16 v[28:31], v[56:59], v[116:119], v[28:31]
    v_mfma_f32_16x16x32_bf16 v[24:27], v[56:59], v[124:127], v[24:27]
    v_mfma_f32_16x16x32_bf16 v[20:23], v[56:59], v[136:139], v[20:23]
    v_mfma_f32_16x16x32_bf16 v[16:19], v[56:59], v[128:131], v[16:19]
    s_waitcnt lgkmcnt(5)
    v_mfma_f32_16x16x32_bf16 v[12:15], v[56:59], v[64:67], v[12:15]
    s_waitcnt lgkmcnt(3)
    v_mfma_f32_16x16x32_bf16 v[44:47], v[60:63], v[92:95], v[44:47]
    v_mfma_f32_16x16x32_bf16 v[40:43], v[60:63], v[100:103], v[40:43]
    v_mfma_f32_16x16x32_bf16 v[36:39], v[60:63], v[104:107], v[36:39]
    ds_read_b128 v[68:71], v149 offset:2016
    v_mfma_f32_16x16x32_bf16 v[32:35], v[60:63], v[116:119], v[32:35]
    ds_read_b32 v148, v2
    v_mfma_f32_16x16x32_bf16 v[28:31], v[60:63], v[124:127], v[28:31]
    v_mfma_f32_16x16x32_bf16 v[24:27], v[60:63], v[136:139], v[24:27]
    v_mfma_f32_16x16x32_bf16 v[20:23], v[60:63], v[128:131], v[20:23]
    v_mfma_f32_16x16x32_bf16 v[16:19], v[60:63], v[64:67], v[16:19]
    s_waitcnt lgkmcnt(4)
    v_mfma_f32_16x16x32_bf16 v[12:15], v[60:63], v[48:51], v[12:15]
    s_waitcnt lgkmcnt(2)
    v_mfma_f32_16x16x32_bf16 v[44:47], v[96:99], v[100:103], v[44:47]
    v_mfma_f32_16x16x32_bf16 v[40:43], v[96:99], v[104:107], v[40:43]
L_chk3:
    s_waitcnt lgkmcnt(0)
    v_cmp_gt_u32 vcc, 3, v148
    ds_read_b32 v148, v2
    s_cbranch_vccnz L_chk3
    ds_read_b64_tr_b16 v[108:109], v4 offset:20480
    ds_read_b64_tr_b16 v[110:111], v4 offset:20736
    v_mfma_f32_16x16x32_bf16 v[36:39], v[96:99], v[116:119], v[36:39]
    ds_read_b128 v[72:75], v149 offset:1920
    v_mfma_f32_16x16x32_bf16 v[32:35], v[96:99], v[124:127], v[32:35]
    ds_read_b64_tr_b16 v[112:113], v4 offset:22528
    ds_read_b64_tr_b16 v[114:115], v4 offset:22784
    v_mfma_f32_16x16x32_bf16 v[28:31], v[96:99], v[136:139], v[28:31]
    v_mfma_f32_16x16x32_bf16 v[24:27], v[96:99], v[128:131], v[24:27]
    v_mfma_f32_16x16x32_bf16 v[20:23], v[96:99], v[64:67], v[20:23]
    v_mfma_f32_16x16x32_bf16 v[16:19], v[96:99], v[48:51], v[16:19]
    v_mfma_f32_16x16x32_bf16 v[12:15], v[96:99], v[68:71], v[12:15]
    s_waitcnt lgkmcnt(3)
    v_mfma_f32_16x16x32_bf16 v[44:47], v[108:111], v[104:107], v[44:47]
    v_mfma_f32_16x16x32_bf16 v[40:43], v[108:111], v[116:119], v[40:43]
    v_mfma_f32_16x16x32_bf16 v[36:39], v[108:111], v[124:127], v[36:39]
    ds_read_b128 v[76:79], v149 offset:1824
    v_mfma_f32_16x16x32_bf16 v[32:35], v[108:111], v[136:139], v[32:35]
    ds_read_b64_tr_b16 v[120:121], v4 offset:24576
    ds_read_b64_tr_b16 v[122:123], v4 offset:24832
    v_mfma_f32_16x16x32_bf16 v[28:31], v[108:111], v[128:131], v[28:31]
    v_mfma_f32_16x16x32_bf16 v[24:27], v[108:111], v[64:67], v[24:27]
    v_mfma_f32_16x16x32_bf16 v[20:23], v[108:111], v[48:51], v[20:23]
    v_mfma_f32_16x16x32_bf16 v[16:19], v[108:111], v[68:71], v[16:19]
    s_waitcnt lgkmcnt(5)
    v_mfma_f32_16x16x32_bf16 v[12:15], v[108:111], v[72:75], v[12:15]
    s_waitcnt lgkmcnt(3)
    v_mfma_f32_16x16x32_bf16 v[44:47], v[112:115], v[116:119], v[44:47]
    v_mfma_f32_16x16x32_bf16 v[40:43], v[112:115], v[124:127], v[40:43]
    v_mfma_f32_16x16x32_bf16 v[36:39], v[112:115], v[136:139], v[36:39]
    ds_read_b128 v[80:83], v149 offset:1728
    v_mfma_f32_16x16x32_bf16 v[32:35], v[112:115], v[128:131], v[32:35]
    ds_read_b64_tr_b16 v[132:133], v4 offset:26624
    ds_read_b64_tr_b16 v[134:135], v4 offset:26880
    v_mfma_f32_16x16x32_bf16 v[28:31], v[112:115], v[64:67], v[28:31]
    v_mfma_f32_16x16x32_bf16 v[24:27], v[112:115], v[48:51], v[24:27]
    v_mfma_f32_16x16x32_bf16 v[20:23], v[112:115], v[68:71], v[20:23]
    v_mfma_f32_16x16x32_bf16 v[16:19], v[112:115], v[72:75], v[16:19]
    s_waitcnt lgkmcnt(5)
    v_mfma_f32_16x16x32_bf16 v[12:15], v[112:115], v[76:79], v[12:15]
    s_waitcnt lgkmcnt(3)
    v_mfma_f32_16x16x32_bf16 v[44:47], v[120:123], v[124:127], v[44:47]
    v_mfma_f32_16x16x32_bf16 v[40:43], v[120:123], v[136:139], v[40:43]
    v_mfma_f32_16x16x32_bf16 v[36:39], v[120:123], v[128:131], v[36:39]
    ds_read_b128 v[88:91], v149 offset:1632
    v_mfma_f32_16x16x32_bf16 v[32:35], v[120:123], v[64:67], v[32:35]
    ds_read_b64_tr_b16 v[52:53], v4 offset:28672
    ds_read_b64_tr_b16 v[54:55], v4 offset:28928
    v_mfma_f32_16x16x32_bf16 v[28:31], v[120:123], v[48:51], v[28:31]
    v_mfma_f32_16x16x32_bf16 v[24:27], v[120:123], v[68:71], v[24:27]
    v_mfma_f32_16x16x32_bf16 v[20:23], v[120:123], v[72:75], v[20:23]
    v_mfma_f32_16x16x32_bf16 v[16:19], v[120:123], v[76:79], v[16:19]
    s_waitcnt lgkmcnt(5)
    v_mfma_f32_16x16x32_bf16 v[12:15], v[120:123], v[80:83], v[12:15]
    s_waitcnt lgkmcnt(3)
    v_mfma_f32_16x16x32_bf16 v[44:47], v[132:135], v[136:139], v[44:47]
    v_mfma_f32_16x16x32_bf16 v[40:43], v[132:135], v[128:131], v[40:43]
    v_mfma_f32_16x16x32_bf16 v[36:39], v[132:135], v[64:67], v[36:39]
    ds_read_b128 v[84:87], v149 offset:1536
    v_mfma_f32_16x16x32_bf16 v[32:35], v[132:135], v[48:51], v[32:35]
    ds_read_b64_tr_b16 v[56:57], v4 offset:30720
    ds_read_b64_tr_b16 v[58:59], v4 offset:30976
    v_mfma_f32_16x16x32_bf16 v[28:31], v[132:135], v[68:71], v[28:31]
    v_mfma_f32_16x16x32_bf16 v[24:27], v[132:135], v[72:75], v[24:27]
    v_mfma_f32_16x16x32_bf16 v[20:23], v[132:135], v[76:79], v[20:23]
    v_mfma_f32_16x16x32_bf16 v[16:19], v[132:135], v[80:83], v[16:19]
    s_waitcnt lgkmcnt(5)
    v_mfma_f32_16x16x32_bf16 v[12:15], v[132:135], v[88:91], v[12:15]
    s_waitcnt lgkmcnt(3)
    v_mfma_f32_16x16x32_bf16 v[44:47], v[52:55], v[128:131], v[44:47]
    v_mfma_f32_16x16x32_bf16 v[40:43], v[52:55], v[64:67], v[40:43]
    v_mfma_f32_16x16x32_bf16 v[36:39], v[52:55], v[48:51], v[36:39]
    ds_read_b128 v[92:95], v149 offset:1440
    v_mfma_f32_16x16x32_bf16 v[32:35], v[52:55], v[68:71], v[32:35]
    ds_read_b64_tr_b16 v[60:61], v4 offset:32768
    ds_read_b64_tr_b16 v[62:63], v4 offset:33024
    v_mfma_f32_16x16x32_bf16 v[28:31], v[52:55], v[72:75], v[28:31]
    v_mfma_f32_16x16x32_bf16 v[24:27], v[52:55], v[76:79], v[24:27]
    v_mfma_f32_16x16x32_bf16 v[20:23], v[52:55], v[80:83], v[20:23]
    v_mfma_f32_16x16x32_bf16 v[16:19], v[52:55], v[88:91], v[16:19]
    s_waitcnt lgkmcnt(5)
    v_mfma_f32_16x16x32_bf16 v[12:15], v[52:55], v[84:87], v[12:15]
    s_waitcnt lgkmcnt(3)
L_pad2:
    s_cbranch_execz L_pad3
    v_mfma_f32_16x16x32_bf16 v[44:47], v[56:59], v[64:67], v[44:47]
    v_mfma_f32_16x16x32_bf16 v[40:43], v[56:59], v[48:51], v[40:43]
    v_mfma_f32_16x16x32_bf16 v[36:39], v[56:59], v[68:71], v[36:39]
    ds_read_b128 v[100:103], v149 offset:1344
    v_mfma_f32_16x16x32_bf16 v[32:35], v[56:59], v[72:75], v[32:35]
    ds_read_b64_tr_b16 v[96:97], v4 offset:34816
    ds_read_b64_tr_b16 v[98:99], v4 offset:35072
    v_mfma_f32_16x16x32_bf16 v[28:31], v[56:59], v[76:79], v[28:31]
    v_mfma_f32_16x16x32_bf16 v[24:27], v[56:59], v[80:83], v[24:27]
    v_mfma_f32_16x16x32_bf16 v[20:23], v[56:59], v[88:91], v[20:23]
    v_mfma_f32_16x16x32_bf16 v[16:19], v[56:59], v[84:87], v[16:19]
    s_waitcnt lgkmcnt(5)
    v_mfma_f32_16x16x32_bf16 v[12:15], v[56:59], v[92:95], v[12:15]
    s_waitcnt lgkmcnt(3)
    v_mfma_f32_16x16x32_bf16 v[44:47], v[60:63], v[48:51], v[44:47]
    v_mfma_f32_16x16x32_bf16 v[40:43], v[60:63], v[68:71], v[40:43]
    v_mfma_f32_16x16x32_bf16 v[36:39], v[60:63], v[72:75], v[36:39]
    ds_read_b128 v[104:107], v149 offset:1248
    v_mfma_f32_16x16x32_bf16 v[32:35], v[60:63], v[76:79], v[32:35]
    ds_read_b32 v148, v2
    v_mfma_f32_16x16x32_bf16 v[28:31], v[60:63], v[80:83], v[28:31]
    v_mfma_f32_16x16x32_bf16 v[24:27], v[60:63], v[88:91], v[24:27]
    v_mfma_f32_16x16x32_bf16 v[20:23], v[60:63], v[84:87], v[20:23]
    v_mfma_f32_16x16x32_bf16 v[16:19], v[60:63], v[92:95], v[16:19]
    s_waitcnt lgkmcnt(4)
    v_mfma_f32_16x16x32_bf16 v[12:15], v[60:63], v[100:103], v[12:15]
    s_waitcnt lgkmcnt(2)
    v_mfma_f32_16x16x32_bf16 v[44:47], v[96:99], v[68:71], v[44:47]
    v_mfma_f32_16x16x32_bf16 v[40:43], v[96:99], v[72:75], v[40:43]
L_chk4:
    s_waitcnt lgkmcnt(0)
    v_cmp_gt_u32 vcc, 4, v148
    ds_read_b32 v148, v2
    s_cbranch_vccnz L_chk4
    ds_read_b64_tr_b16 v[108:109], v4 offset:36864
    ds_read_b64_tr_b16 v[110:111], v4 offset:37120
    v_mfma_f32_16x16x32_bf16 v[36:39], v[96:99], v[76:79], v[36:39]
    ds_read_b128 v[116:119], v149 offset:1152
    v_mfma_f32_16x16x32_bf16 v[32:35], v[96:99], v[80:83], v[32:35]
    ds_read_b64_tr_b16 v[112:113], v4 offset:38912
    ds_read_b64_tr_b16 v[114:115], v4 offset:39168
    v_mfma_f32_16x16x32_bf16 v[28:31], v[96:99], v[88:91], v[28:31]
    v_mfma_f32_16x16x32_bf16 v[24:27], v[96:99], v[84:87], v[24:27]
    v_mfma_f32_16x16x32_bf16 v[20:23], v[96:99], v[92:95], v[20:23]
    v_mfma_f32_16x16x32_bf16 v[16:19], v[96:99], v[100:103], v[16:19]
    v_mfma_f32_16x16x32_bf16 v[12:15], v[96:99], v[104:107], v[12:15]
    s_waitcnt lgkmcnt(3)
    v_mfma_f32_16x16x32_bf16 v[44:47], v[108:111], v[72:75], v[44:47]
    v_mfma_f32_16x16x32_bf16 v[40:43], v[108:111], v[76:79], v[40:43]
    v_mfma_f32_16x16x32_bf16 v[36:39], v[108:111], v[80:83], v[36:39]
    ds_read_b128 v[124:127], v149 offset:1056
    v_mfma_f32_16x16x32_bf16 v[32:35], v[108:111], v[88:91], v[32:35]
    ds_read_b64_tr_b16 v[120:121], v4 offset:40960
    ds_read_b64_tr_b16 v[122:123], v4 offset:41216
    v_mfma_f32_16x16x32_bf16 v[28:31], v[108:111], v[84:87], v[28:31]
    v_mfma_f32_16x16x32_bf16 v[24:27], v[108:111], v[92:95], v[24:27]
    v_mfma_f32_16x16x32_bf16 v[20:23], v[108:111], v[100:103], v[20:23]
    v_mfma_f32_16x16x32_bf16 v[16:19], v[108:111], v[104:107], v[16:19]
    s_waitcnt lgkmcnt(5)
    v_mfma_f32_16x16x32_bf16 v[12:15], v[108:111], v[116:119], v[12:15]
    s_waitcnt lgkmcnt(3)
    v_mfma_f32_16x16x32_bf16 v[44:47], v[112:115], v[76:79], v[44:47]
    v_mfma_f32_16x16x32_bf16 v[40:43], v[112:115], v[80:83], v[40:43]
    v_mfma_f32_16x16x32_bf16 v[36:39], v[112:115], v[88:91], v[36:39]
    ds_read_b128 v[136:139], v149 offset:960
    v_mfma_f32_16x16x32_bf16 v[32:35], v[112:115], v[84:87], v[32:35]
    ds_read_b64_tr_b16 v[132:133], v4 offset:43008
    ds_read_b64_tr_b16 v[134:135], v4 offset:43264
    v_mfma_f32_16x16x32_bf16 v[28:31], v[112:115], v[92:95], v[28:31]
    v_mfma_f32_16x16x32_bf16 v[24:27], v[112:115], v[100:103], v[24:27]
    v_mfma_f32_16x16x32_bf16 v[20:23], v[112:115], v[104:107], v[20:23]
    v_mfma_f32_16x16x32_bf16 v[16:19], v[112:115], v[116:119], v[16:19]
    s_waitcnt lgkmcnt(5)
    v_mfma_f32_16x16x32_bf16 v[12:15], v[112:115], v[124:127], v[12:15]
    s_waitcnt lgkmcnt(3)
    v_mfma_f32_16x16x32_bf16 v[44:47], v[120:123], v[80:83], v[44:47]
    v_mfma_f32_16x16x32_bf16 v[40:43], v[120:123], v[88:91], v[40:43]
    v_mfma_f32_16x16x32_bf16 v[36:39], v[120:123], v[84:87], v[36:39]
    ds_read_b128 v[128:131], v149 offset:864
    v_mfma_f32_16x16x32_bf16 v[32:35], v[120:123], v[92:95], v[32:35]
    ds_read_b64_tr_b16 v[52:53], v4 offset:45056
    ds_read_b64_tr_b16 v[54:55], v4 offset:45312
    v_mfma_f32_16x16x32_bf16 v[28:31], v[120:123], v[100:103], v[28:31]
    ds_read_b64_tr_b16 v[64:65], v4 offset:47104
    ds_read_b64_tr_b16 v[66:67], v4 offset:47360
    v_mfma_f32_16x16x32_bf16 v[24:27], v[120:123], v[104:107], v[24:27]
    ds_read_b32 v148, v2
    ds_read_b64_tr_b16 v[56:57], v4 offset:49152
    ds_read_b64_tr_b16 v[58:59], v4 offset:49408
    v_mfma_f32_16x16x32_bf16 v[20:23], v[120:123], v[116:119], v[20:23]
    s_waitcnt lgkmcnt(8)
    ds_read_b64_tr_b16 v[48:49], v4 offset:51200
    ds_read_b64_tr_b16 v[50:51], v4 offset:51456
    v_mfma_f32_16x16x32_bf16 v[16:19], v[120:123], v[124:127], v[16:19]
    v_mfma_f32_16x16x32_bf16 v[12:15], v[120:123], v[136:139], v[12:15]
    v_mfma_f32_16x16x32_bf16 v[44:47], v[132:135], v[88:91], v[44:47]
    v_mfma_f32_16x16x32_bf16 v[40:43], v[132:135], v[84:87], v[40:43]
    v_mfma_f32_16x16x32_bf16 v[36:39], v[132:135], v[92:95], v[36:39]
    v_mfma_f32_16x16x32_bf16 v[32:35], v[132:135], v[100:103], v[32:35]
L_chk5:
    s_waitcnt lgkmcnt(0)
    v_cmp_gt_u32 vcc, 5, v148
    ds_read_b32 v148, v2
    s_cbranch_vccnz L_chk5
    ds_read_b64_tr_b16 v[60:61], v4 offset:53248
    ds_read_b64_tr_b16 v[62:63], v4 offset:53504
    v_mfma_f32_16x16x32_bf16 v[28:31], v[132:135], v[104:107], v[28:31]
    ds_read_b64_tr_b16 v[68:69], v4 offset:55296
    ds_read_b64_tr_b16 v[70:71], v4 offset:55552
    v_mfma_f32_16x16x32_bf16 v[24:27], v[132:135], v[116:119], v[24:27]
    ds_read_b64_tr_b16 v[96:97], v4 offset:57344
    ds_read_b64_tr_b16 v[98:99], v4 offset:57600
    v_mfma_f32_16x16x32_bf16 v[20:23], v[132:135], v[124:127], v[20:23]
    ds_read_b64_tr_b16 v[72:73], v4 offset:59392
    ds_read_b64_tr_b16 v[74:75], v4 offset:59648
    v_mfma_f32_16x16x32_bf16 v[16:19], v[132:135], v[136:139], v[16:19]
    ds_read_b64_tr_b16 v[108:109], v4 offset:61440
    ds_read_b64_tr_b16 v[110:111], v4 offset:61696
    v_mfma_f32_16x16x32_bf16 v[12:15], v[132:135], v[128:131], v[12:15]
    ds_read_b128 v[76:79], v149 offset:768
    v_mfma_f32_16x16x32_bf16 v[44:47], v[52:55], v[84:87], v[44:47]
    ds_read_b128 v[112:115], v149 offset:672
L_pad3:
    s_cbranch_execz L_pad4
    v_mfma_f32_16x16x32_bf16 v[44:47], v[64:67], v[92:95], v[44:47]
    v_mfma_f32_16x16x32_bf16 v[44:47], v[56:59], v[100:103], v[44:47]
    s_waitcnt lgkmcnt(11)
    v_mfma_f32_16x16x32_bf16 v[44:47], v[48:51], v[104:107], v[44:47]
    s_waitcnt lgkmcnt(8)
    v_mfma_f32_16x16x32_bf16 v[44:47], v[60:63], v[116:119], v[44:47]
    ds_read_b32 v148, v150
    v_mfma_f32_16x16x32_bf16 v[44:47], v[68:71], v[124:127], v[44:47]
    s_waitcnt lgkmcnt(7)
    v_mfma_f32_16x16x32_bf16 v[44:47], v[96:99], v[136:139], v[44:47]
    s_waitcnt lgkmcnt(5)
    v_mfma_f32_16x16x32_bf16 v[44:47], v[72:75], v[128:131], v[44:47]
    ds_read_b128 v[80:83], v149 offset:576
    s_waitcnt lgkmcnt(3)
    v_mfma_f32_16x16x32_bf16 v[44:47], v[108:111], v[76:79], v[44:47]
    v_mfma_f32_16x16x32_bf16 v[40:43], v[52:55], v[92:95], v[40:43]
    v_mfma_f32_16x16x32_bf16 v[40:43], v[64:67], v[100:103], v[40:43]
    v_mfma_f32_16x16x32_bf16 v[40:43], v[56:59], v[104:107], v[40:43]
L_chk7:
    s_waitcnt lgkmcnt(0)
    v_cmp_eq_u32 vcc, 0, v148
    v_mov_b32 v153, v148
    ds_read_b32 v148, v150
    s_cbranch_vccnz L_chk7
    v_cvt_pk_bf16_f32 v140, v44, v45
    v_mfma_f32_16x16x32_bf16 v[40:43], v[48:51], v[116:119], v[40:43]
    v_cvt_pk_bf16_f32 v141, v46, v47
    v_mfma_f32_16x16x32_bf16 v[40:43], v[60:63], v[124:127], v[40:43]
    buffer_store_dwordx2 v[140:141], v7, s[36:39], 0 offen sc1
    v_mfma_f32_16x16x32_bf16 v[40:43], v[68:71], v[136:139], v[40:43]
    v_add_u32 v157, v140, v141
    v_mfma_f32_16x16x32_bf16 v[40:43], v[96:99], v[128:131], v[40:43]
    v_mfma_f32_16x16x32_bf16 v[40:43], v[72:75], v[76:79], v[40:43]
    ds_read_b128 v[120:123], v149 offset:480
    v_add_u32_dpp v156, v157, v157 quad_perm:[1,0,3,2] row_mask:0xf bank_mask:0xf
    v_mfma_f32_16x16x32_bf16 v[40:43], v[108:111], v[112:115], v[40:43]
    v_add_u32 v156, v156, v153
    v_mfma_f32_16x16x32_bf16 v[36:39], v[52:55], v[100:103], v[36:39]
    v_mov_b32 v157, v156
    v_mfma_f32_16x16x32_bf16 v[36:39], v[64:67], v[104:107], v[36:39]
    v_mfma_f32_16x16x32_bf16 v[36:39], v[56:59], v[116:119], v[36:39]
    v_permlane16_swap_b32 v156, v157
    v_mfma_f32_16x16x32_bf16 v[36:39], v[48:51], v[124:127], v[36:39]
    v_mov_b32 v158, v156
    v_mov_b32 v159, v157
    v_mfma_f32_16x16x32_bf16 v[36:39], v[60:63], v[136:139], v[36:39]
    v_mfma_f32_16x16x32_bf16 v[36:39], v[68:71], v[128:131], v[36:39]
    v_permlane32_swap_b32 v156, v158
    v_permlane32_swap_b32 v157, v159
    v_mfma_f32_16x16x32_bf16 v[36:39], v[96:99], v[76:79], v[36:39]
    buffer_store_dwordx4 v[156:159], v152, s[36:39], 0 offen sc1
    v_mfma_f32_16x16x32_bf16 v[36:39], v[72:75], v[112:115], v[36:39]
    ds_read_b128 v[88:91], v149 offset:384
    v_mfma_f32_16x16x32_bf16 v[36:39], v[108:111], v[80:83], v[36:39]
    v_cvt_pk_bf16_f32 v146, v40, v41
    v_mfma_f32_16x16x32_bf16 v[32:35], v[52:55], v[104:107], v[32:35]
    v_cvt_pk_bf16_f32 v147, v42, v43
    v_mfma_f32_16x16x32_bf16 v[32:35], v[64:67], v[116:119], v[32:35]
    v_add3_u32 v160, v146, v147, v153
    v_mfma_f32_16x16x32_bf16 v[32:35], v[56:59], v[124:127], v[32:35]
    v_mfma_f32_16x16x32_bf16 v[32:35], v[48:51], v[136:139], v[32:35]
    v_mfma_f32_16x16x32_bf16 v[32:35], v[60:63], v[128:131], v[32:35]
    v_cvt_pk_bf16_f32 v144, v36, v37
    v_mfma_f32_16x16x32_bf16 v[32:35], v[68:71], v[76:79], v[32:35]
    v_cvt_pk_bf16_f32 v145, v38, v39
    v_mfma_f32_16x16x32_bf16 v[32:35], v[96:99], v[112:115], v[32:35]
    buffer_store_dwordx4 v[144:147], v6, s[36:39], s62 offen sc1
    v_mfma_f32_16x16x32_bf16 v[32:35], v[72:75], v[80:83], v[32:35]
    ds_read_b128 v[132:135], v149 offset:288
    v_add3_u32 v160, v160, v144, v145
    s_waitcnt lgkmcnt(2)
    v_mfma_f32_16x16x32_bf16 v[32:35], v[108:111], v[120:123], v[32:35]
    v_mov_b32 v161, v160
    v_mfma_f32_16x16x32_bf16 v[28:31], v[52:55], v[116:119], v[28:31]
    v_mfma_f32_16x16x32_bf16 v[28:31], v[64:67], v[124:127], v[28:31]
    v_permlane16_swap_b32 v160, v161
    v_mfma_f32_16x16x32_bf16 v[28:31], v[56:59], v[136:139], v[28:31]
    v_mov_b32 v162, v160
    v_mov_b32 v163, v161
    v_mfma_f32_16x16x32_bf16 v[28:31], v[48:51], v[128:131], v[28:31]
    v_mfma_f32_16x16x32_bf16 v[28:31], v[60:63], v[76:79], v[28:31]
    v_permlane32_swap_b32 v160, v162
    v_permlane32_swap_b32 v161, v163
    v_mfma_f32_16x16x32_bf16 v[28:31], v[68:71], v[112:115], v[28:31]
    buffer_store_dwordx4 v[160:163], v151, s[36:39], s62 offen sc1
    v_mfma_f32_16x16x32_bf16 v[28:31], v[96:99], v[80:83], v[28:31]
    v_mfma_f32_16x16x32_bf16 v[28:31], v[72:75], v[120:123], v[28:31]
    ds_read_b128 v[84:87], v149 offset:192
    v_cvt_pk_bf16_f32 v142, v32, v33
    s_waitcnt lgkmcnt(2)
    v_mfma_f32_16x16x32_bf16 v[28:31], v[108:111], v[88:91], v[28:31]
    v_cvt_pk_bf16_f32 v143, v34, v35
    v_mfma_f32_16x16x32_bf16 v[24:27], v[52:55], v[124:127], v[24:27]
    v_add3_u32 v156, v142, v143, v153
    v_mfma_f32_16x16x32_bf16 v[24:27], v[64:67], v[136:139], v[24:27]
    v_mfma_f32_16x16x32_bf16 v[24:27], v[56:59], v[128:131], v[24:27]
    v_mfma_f32_16x16x32_bf16 v[24:27], v[48:51], v[76:79], v[24:27]
    v_mfma_f32_16x16x32_bf16 v[24:27], v[60:63], v[112:115], v[24:27]
    v_mfma_f32_16x16x32_bf16 v[24:27], v[68:71], v[80:83], v[24:27]
    v_cvt_pk_bf16_f32 v140, v28, v29
    v_mfma_f32_16x16x32_bf16 v[24:27], v[96:99], v[120:123], v[24:27]
    v_cvt_pk_bf16_f32 v141, v30, v31
    v_mfma_f32_16x16x32_bf16 v[24:27], v[72:75], v[88:91], v[24:27]
    ds_read_b128 v[92:95], v149 offset:96
    buffer_store_dwordx4 v[140:143], v6, s[36:39], s61 offen sc1
    s_waitcnt lgkmcnt(2)
    v_mfma_f32_16x16x32_bf16 v[24:27], v[108:111], v[132:135], v[24:27]
    v_add3_u32 v156, v156, v140, v141
    v_mfma_f32_16x16x32_bf16 v[20:23], v[52:55], v[136:139], v[20:23]
    v_mov_b32 v157, v156
    v_mfma_f32_16x16x32_bf16 v[20:23], v[64:67], v[128:131], v[20:23]
    v_mfma_f32_16x16x32_bf16 v[20:23], v[56:59], v[76:79], v[20:23]
    v_permlane16_swap_b32 v156, v157
    v_mfma_f32_16x16x32_bf16 v[20:23], v[48:51], v[112:115], v[20:23]
    v_mov_b32 v158, v156
    v_mov_b32 v159, v157
    v_mfma_f32_16x16x32_bf16 v[20:23], v[60:63], v[80:83], v[20:23]
    v_mfma_f32_16x16x32_bf16 v[20:23], v[68:71], v[120:123], v[20:23]
    v_permlane32_swap_b32 v156, v158
    v_permlane32_swap_b32 v157, v159
    v_mfma_f32_16x16x32_bf16 v[20:23], v[96:99], v[88:91], v[20:23]
L_pad4:
    s_cbranch_execz L_pad5
    buffer_store_dwordx4 v[156:159], v151, s[36:39], s61 offen sc1
    v_mfma_f32_16x16x32_bf16 v[20:23], v[72:75], v[132:135], v[20:23]
    ds_read_b128 v[100:103], v149 offset:0
    s_waitcnt lgkmcnt(2)
    v_mfma_f32_16x16x32_bf16 v[20:23], v[108:111], v[84:87], v[20:23]
    v_cvt_pk_bf16_f32 v146, v24, v25
    v_mfma_f32_16x16x32_bf16 v[16:19], v[52:55], v[128:131], v[16:19]
    v_cvt_pk_bf16_f32 v147, v26, v27
    v_mfma_f32_16x16x32_bf16 v[16:19], v[64:67], v[76:79], v[16:19]
    v_add3_u32 v160, v146, v147, v153
    v_mfma_f32_16x16x32_bf16 v[16:19], v[56:59], v[112:115], v[16:19]
    v_mfma_f32_16x16x32_bf16 v[16:19], v[48:51], v[80:83], v[16:19]
    v_mfma_f32_16x16x32_bf16 v[16:19], v[60:63], v[120:123], v[16:19]
    v_cvt_pk_bf16_f32 v144, v20, v21
    v_mfma_f32_16x16x32_bf16 v[16:19], v[68:71], v[88:91], v[16:19]
    v_cvt_pk_bf16_f32 v145, v22, v23
    v_mfma_f32_16x16x32_bf16 v[16:19], v[96:99], v[132:135], v[16:19]
    buffer_store_dwordx4 v[144:147], v6, s[36:39], s60 offen sc1
    v_mfma_f32_16x16x32_bf16 v[16:19], v[72:75], v[84:87], v[16:19]
    v_add3_u32 v160, v160, v144, v145
    s_waitcnt lgkmcnt(1)
    v_mfma_f32_16x16x32_bf16 v[16:19], v[108:111], v[92:95], v[16:19]
    v_mov_b32 v161, v160
    v_mfma_f32_16x16x32_bf16 v[12:15], v[52:55], v[76:79], v[12:15]
    v_mfma_f32_16x16x32_bf16 v[12:15], v[64:67], v[112:115], v[12:15]
    v_permlane16_swap_b32 v160, v161
    v_mfma_f32_16x16x32_bf16 v[12:15], v[56:59], v[80:83], v[12:15]
    v_mov_b32 v162, v160
    v_mov_b32 v163, v161
    v_mfma_f32_16x16x32_bf16 v[12:15], v[48:51], v[120:123], v[12:15]
    v_mfma_f32_16x16x32_bf16 v[12:15], v[60:63], v[88:91], v[12:15]
    v_permlane32_swap_b32 v160, v162
    v_permlane32_swap_b32 v161, v163
    v_mfma_f32_16x16x32_bf16 v[12:15], v[68:71], v[132:135], v[12:15]
    buffer_store_dwordx4 v[160:163], v151, s[36:39], s60 offen sc1
    v_mfma_f32_16x16x32_bf16 v[12:15], v[96:99], v[84:87], v[12:15]
    s_waitcnt vmcnt(6)
    ds_add_u32 v155, v154
    v_mfma_f32_16x16x32_bf16 v[12:15], v[72:75], v[92:95], v[12:15]
    v_cvt_pk_bf16_f32 v142, v16, v17
    s_waitcnt lgkmcnt(1)
    v_mfma_f32_16x16x32_bf16 v[12:15], v[108:111], v[100:103], v[12:15]
    v_cvt_pk_bf16_f32 v143, v18, v19
    v_add3_u32 v156, v142, v143, v153
    s_nop 5
    v_cvt_pk_bf16_f32 v140, v12, v13
    v_cvt_pk_bf16_f32 v141, v14, v15
    buffer_store_dwordx4 v[140:143], v6, s[36:39], 0 offen sc1
    v_add3_u32 v156, v156, v140, v141
    v_mov_b32 v157, v156
    s_nop 1
    v_permlane16_swap_b32 v156, v157
    v_mov_b32 v158, v156
    v_mov_b32 v159, v157
    s_nop 1
    v_permlane32_swap_b32 v156, v158
    v_permlane32_swap_b32 v157, v159
    buffer_store_dwordx4 v[156:159], v151, s[36:39], 0 offen sc1
    s_waitcnt vmcnt(6)
    ds_add_u32 v155, v154
    s_setprio 0
    s_waitcnt vmcnt(4)
    ds_add_u32 v155, v154
    s_waitcnt vmcnt(2)
    ds_add_u32 v155, v154
    s_waitcnt vmcnt(0)
    ds_add_u32 v155, v154
    ds_read_b128 v[136:139], v164 offset:3072
    ds_read_b64 v[140:141], v164 offset:4096
    ds_read_b32 v148, v2
L_chkwo:
    s_waitcnt lgkmcnt(0)
    v_cmp_gt_u32 vcc, 6, v148
    ds_read_b32 v148, v2
    s_cbranch_vccnz L_chkwo
    s_lshl_b32 s47, s43, 5
    v_add_u32 v138, s47, v138
    v_add_u32 v139, s47, v139
    ds_read_b64_tr_b16 v[48:49], v138 offset:0
    ds_read_b64_tr_b16 v[50:51], v138 offset:1152
    ds_read_b64_tr_b16 v[52:53], v138 offset:9216
    ds_read_b64_tr_b16 v[54:55], v138 offset:10368
    ds_read_b64_tr_b16 v[56:57], v138 offset:18432
    ds_read_b64_tr_b16 v[58:59], v138 offset:19584
    ds_read_b64_tr_b16 v[60:61], v138 offset:27648
    ds_read_b64_tr_b16 v[62:63], v138 offset:28800
    ds_read_b64_tr_b16 v[64:65], v139 offset:36864
    s_branch L_p2
L_help:
    ds_read_b32 v148, v135
    s_sleep 1
    s_waitcnt lgkmcnt(0)
    v_cmp_gt_u32 vcc, v141, v148
    s_cbranch_vccnz L_help
    v_readlane_b32 s54, v148, 4
    s_mov_b32 s55, 0
L_hwo:
    ds_read_b32 v148, v135
    s_waitcnt lgkmcnt(0)
    v_cmp_gt_u32 vcc, 6, v148
    s_and_b64 vcc, vcc, 15
    s_cbranch_vccnz L_hwo
    ds_read_b64_tr_b16 v[48:49], v138 offset:0
    ds_read_b64_tr_b16 v[50:51], v138 offset:1152
    ds_read_b64_tr_b16 v[52:53], v138 offset:9216
    ds_read_b64_tr_b16 v[54:55], v138 offset:10368
    ds_read_b64_tr_b16 v[56:57], v138 offset:18432
    ds_read_b64_tr_b16 v[58:59], v138 offset:19584
    ds_read_b64_tr_b16 v[60:61], v138 offset:27648
    ds_read_b64_tr_b16 v[62:63], v138 offset:28800
    ds_read_b64_tr_b16 v[64:65], v139 offset:36864
    s_waitcnt lgkmcnt(0)
    s_sleep 2
P2_retry:
    buffer_load_dwordx4 v[68:71], v132, s[36:39], s97 offen sc1
    buffer_load_dwordx4 v[72:75], v132, s[36:39], s97 offen offset:2304 sc1
    buffer_load_dwordx4 v[76:79], v132, s[36:39], s96 offen sc1
    buffer_load_dwordx4 v[80:83], v132, s[36:39], s96 offen offset:2304 sc1
    buffer_load_dwordx4 v[92:95], v133, s[36:39], s97 offen sc1
    s_add_u32 s55, s55, 1
    s_cmp_lt_u32 s55, 262144
    s_cselect_b64 s[58:59], -1, 0
    s_waitcnt vmcnt(3)
    v_mfma_f32_16x16x32_bf16 v[84:87], v[124:127], v[68:71], 0
L_pad5:
    s_cbranch_execz L_pad6
    v_mfma_f32_16x16x32_bf16 v[84:87], v[128:131], v[72:75], v[84:87]
    v_add3_u32 v96, v68, v69, v70
    v_add3_u32 v97, v72, v73, v74
    v_add3_u32 v96, v96, v71, s54
    v_add3_u32 v97, v97, v75, s54
    s_waitcnt vmcnt(1)
    v_mfma_f32_16x16x32_bf16 v[88:91], v[124:127], v[76:79], 0
    v_mfma_f32_16x16x32_bf16 v[88:91], v[128:131], v[80:83], v[88:91]
    v_add3_u32 v98, v76, v77, v78
    v_add3_u32 v99, v80, v81, v82
    v_add3_u32 v98, v98, v79, s54
    v_add3_u32 v99, v99, v83, s54
    s_waitcnt vmcnt(0)
    ds_write_b128 v165, v[92:95]
    ds_read_b32 v92, v166 offset:0
    ds_read_b32 v93, v166 offset:256
    ds_read_b32 v94, v166 offset:512
    ds_read_b32 v95, v166 offset:768
    v_mul_f32 v156, 0x4038aa3b, v84
    v_mul_f32 v157, 0x4038aa3b, v85
    v_mul_f32 v158, 0xbfb8aa3b, v86
    v_mul_f32 v159, 0xbfb8aa3b, v87
    v_mul_f32 v160, 0x4038aa3b, v88
    v_mul_f32 v161, 0x4038aa3b, v89
    v_mul_f32 v162, 0xbfb8aa3b, v90
    v_mul_f32 v163, 0xbfb8aa3b, v91
    v_exp_f32 v156, v156
    v_exp_f32 v157, v157
    v_exp_f32 v158, v158
    v_exp_f32 v159, v159
    v_exp_f32 v160, v160
    v_exp_f32 v161, v161
    v_exp_f32 v162, v162
    v_exp_f32 v163, v163
    v_add_f32 v156, 1.0, v156
    v_add_f32 v157, 1.0, v157
    v_add_f32 v158, 1.0, v158
    v_add_f32 v159, 1.0, v159
    v_add_f32 v160, 1.0, v160
    v_add_f32 v161, 1.0, v161
    v_add_f32 v162, 1.0, v162
    v_add_f32 v163, 1.0, v163
    v_rcp_f32 v156, v156
    v_rcp_f32 v157, v157
    v_rcp_f32 v158, v158
    v_rcp_f32 v159, v159
    v_rcp_f32 v160, v160
    v_rcp_f32 v161, v161
    v_rcp_f32 v162, v162
    v_rcp_f32 v163, v163
    v_fma_f32 v156, v156, -2.0, 1.0
    v_fma_f32 v157, v157, -2.0, 1.0
    v_fma_f32 v160, v160, -2.0, 1.0
    v_fma_f32 v161, v161, -2.0, 1.0
    v_mul_f32 v156, v156, v158
    v_mul_f32 v157, v157, v159
    v_mul_f32 v160, v160, v162
    v_mul_f32 v161, v161, v163
    v_cvt_pk_bf16_f32 v156, v156, v157
    v_cvt_pk_bf16_f32 v160, v160, v161
    ds_write_b32 v134, v156 offset:0
    ds_write_b32 v134, v160 offset:160
    s_waitcnt lgkmcnt(0)
    v_cmp_ne_u32 vcc, v98, v94
    v_cmp_ne_u32 s[56:57], v99, v95
    s_or_b64 vcc, vcc, s[56:57]
    s_and_b64 vcc, vcc, s[44:45]
    v_cmp_ne_u32 s[56:57], v96, v92
    s_or_b64 vcc, vcc, s[56:57]
    v_cmp_ne_u32 s[56:57], v97, v93
    s_or_b64 vcc, vcc, s[56:57]
    s_and_b64 vcc, vcc, s[58:59]
    s_cbranch_vccnz P2_retry
L_p2:
    s_waitcnt lgkmcnt(0)
    s_barrier
    ds_read_b128 v[96:99], v136 offset:0
    ds_read_b128 v[100:103], v136 offset:64
    ds_read_b128 v[104:107], v136 offset:128
    ds_read_b128 v[108:111], v136 offset:192
    ds_read_b64 v[112:113], v137 offset:256
    s_waitcnt lgkmcnt(4)
    v_mfma_f32_16x16x32_bf16 v[116:119], v[48:51], v[96:99], 0
    s_waitcnt lgkmcnt(3)
    v_mfma_f32_16x16x32_bf16 v[116:119], v[52:55], v[100:103], v[116:119]
    s_waitcnt lgkmcnt(2)
    v_mfma_f32_16x16x32_bf16 v[116:119], v[56:59], v[104:107], v[116:119]
    s_waitcnt lgkmcnt(1)
    v_mfma_f32_16x16x32_bf16 v[116:119], v[60:63], v[108:111], v[116:119]
    s_waitcnt lgkmcnt(0)
    v_mfma_f32_16x16x16_bf16 v[120:123], v[64:65], v[112:113], 0
    s_nop 7
    v_add_f32 v116, v116, v120
    v_add_f32 v117, v117, v121
    v_add_f32 v118, v118, v122
    v_add_f32 v119, v119, v123
    v_cvt_pk_bf16_f32 v116, v116, v117
    v_cvt_pk_bf16_f32 v117, v118, v119
    buffer_store_dwordx2 v[116:117], v140, s[28:31], s47 offen
L_pad6:
    s_cbranch_execz L_warm_done
L_done:
    s_endpgm
L_end:
.section .rodata,"a"
.p2align 6
.amdhsa_kernel standalone__autoregressive_conv_wavenet__speech_kernel
  .amdhsa_next_free_vgpr 168
  .amdhsa_next_free_sgpr 102
  .amdhsa_accum_offset 168
  .amdhsa_group_segment_fixed_size 0
  .amdhsa_kernarg_size 48
  .amdhsa_user_sgpr_count 2
  .amdhsa_user_sgpr_kernarg_segment_ptr 1
  .amdhsa_system_sgpr_workgroup_id_x 1
.end_amdhsa_kernel
```
